```python
import torch

def _softmax(x, axis=-1):
    return torch.softmax(x, dim=axis)
def _gelu(x):
    return torch.nn.functional.gelu(x, approximate="tanh")
def _silu(x):
    return torch.nn.functional.silu(x)
def _sigmoid(x):
    return torch.sigmoid(x)
def _layernorm(x, axis=-1, eps=1e-5):
    m = x.mean(dim=axis, keepdim=True)
    v = x.var(dim=axis, keepdim=True, unbiased=False)
    return (x - m) / torch.sqrt(v + eps)
def _scatter_add(tgt, idx, src, axis=0):
    return tgt.clone().index_add_(axis, idx, src)
def _segment_sum(src, seg, n):
    out = torch.zeros((n,) + src.shape[1:], dtype=src.dtype)
    return out.index_add_(0, seg, src)
def _pad(x, pw):
    flat = tuple(v for pair in reversed(pw) for v in pair)
    return torch.nn.functional.pad(x, flat)

kernel_name = 'standalone__deepnorm__sampling'

def setup_inputs():

    _w = (lambda a: (lambda t: t.to(torch.bfloat16) if t.is_floating_point() else t)(torch.as_tensor(a)))
    B, S, D = 1024, 8, 512
    return {
        "x": _w((lambda *s: torch.randn(*s, dtype=torch.bfloat16) * 0.05)(B, S, D)),
        "f": _w((lambda *s: torch.randn(*s, dtype=torch.bfloat16) * 0.05)(B, S, D)),
        "g": _w((lambda *s: torch.randn(*s, dtype=torch.bfloat16) * 0.05)(D) + 1.0),
        "b": _w((lambda *s: torch.randn(*s, dtype=torch.bfloat16) * 0.4)(D)),
        "alpha": _w(float(2.0)),
    }

def reference(x, f, g, b, alpha):
    return _layernorm(alpha * x + f, axis=-1) * g + b
```

```asm
; @launch grid=(512,1,1) block=(1024,1,1) lds=0
.amdgcn_target "amdgcn-amd-amdhsa--gfx950"
.text
.globl standalone__deepnorm__sampling_kernel
.p2align 8
.type standalone__deepnorm__sampling_kernel,@function
standalone__deepnorm__sampling_kernel:
    s_load_dwordx16 s[4:19], s[0:1], 0
    s_cmpk_ge_u32 s2, 512
    s_cbranch_scc1 L_done
    s_lshr_b32 s3, s2, 3
    s_mulk_i32 s3, 120
    s_add_u32 s3, s3, s2
    s_lshl_b32 s3, s3, 10
    v_and_b32 v2, 63, v0
    v_lshlrev_b32 v2, 4, v2
    v_lshrrev_b32 v3, 6, v0
    v_add_u32 v1, s3, v2
    v_lshl_add_u32 v1, v3, 13, v1
    s_waitcnt lgkmcnt(0)
    global_load_dwordx4 v[4:7], v1, s[4:5] nt
    global_load_dwordx4 v[8:11], v1, s[6:7] nt
    s_load_dword s16, s[12:13], 0
    global_load_dwordx4 v[12:15], v2, s[8:9]
    global_load_dwordx4 v[16:19], v2, s[10:11]
    v_mov_b32 v3, 0xbb000000
    s_mov_b32 s18, 0x3b000000
    s_mov_b32 s19, 0xffff0000
    v_mov_b32 v0, 0x3727c5ac
    s_waitcnt lgkmcnt(0)
    s_lshl_b32 s16, s16, 16
    s_waitcnt vmcnt(2)
    v_lshlrev_b32 v36, 16, v4
    v_and_b32 v37, s19, v4
    v_lshlrev_b32 v38, 16, v5
    v_and_b32 v39, s19, v5
    v_lshlrev_b32 v40, 16, v6
    v_and_b32 v41, s19, v6
    v_lshlrev_b32 v42, 16, v7
    v_and_b32 v43, s19, v7
    v_lshlrev_b32 v4, 16, v8
    v_and_b32 v5, s19, v8
    v_lshlrev_b32 v6, 16, v9
    v_and_b32 v7, s19, v9
    v_lshlrev_b32 v44, 16, v10
    v_and_b32 v45, s19, v10
    v_lshlrev_b32 v46, 16, v11
    v_and_b32 v47, s19, v11
    v_pk_fma_f32 v[36:37], v[36:37], s[16:17], v[4:5] op_sel_hi:[1,0,1]
    v_pk_fma_f32 v[38:39], v[38:39], s[16:17], v[6:7] op_sel_hi:[1,0,1]
    v_pk_fma_f32 v[40:41], v[40:41], s[16:17], v[44:45] op_sel_hi:[1,0,1]
    v_pk_fma_f32 v[42:43], v[42:43], s[16:17], v[46:47] op_sel_hi:[1,0,1]
    v_pk_add_f32 v[44:45], v[36:37], v[38:39]
    v_pk_add_f32 v[46:47], v[40:41], v[42:43]
    v_pk_add_f32 v[44:45], v[44:45], v[46:47]
    v_add_f32 v44, v44, v45
    s_waitcnt vmcnt(0)
    v_lshlrev_b32 v20, 16, v12
    v_add_f32_dpp v44, v44, v44 quad_perm:[1,0,3,2] row_mask:0xf bank_mask:0xf
    v_and_b32 v21, s19, v12
    v_lshlrev_b32 v22, 16, v13
    v_add_f32_dpp v44, v44, v44 quad_perm:[2,3,0,1] row_mask:0xf bank_mask:0xf
    v_and_b32 v23, s19, v13
    v_lshlrev_b32 v24, 16, v14
    v_add_f32_dpp v44, v44, v44 row_half_mirror row_mask:0xf bank_mask:0xf
    v_and_b32 v25, s19, v14
    v_lshlrev_b32 v26, 16, v15
    v_add_f32_dpp v44, v44, v44 row_mirror row_mask:0xf bank_mask:0xf
    v_and_b32 v27, s19, v15
    v_lshlrev_b32 v28, 16, v16
    v_add_f32_dpp v44, v44, v44 row_bcast:15 row_mask:0xa bank_mask:0xf
    v_and_b32 v29, s19, v16
    v_lshlrev_b32 v30, 16, v17
    v_add_f32_dpp v44, v44, v44 row_bcast:31 row_mask:0xc bank_mask:0xf
    v_and_b32 v31, s19, v17
    v_readlane_b32 s20, v44, 63
    v_lshlrev_b32 v32, 16, v18
    v_and_b32 v33, s19, v18
    v_pk_fma_f32 v[36:37], s[20:21], v[2:3], v[36:37] op_sel:[0,1,0] op_sel_hi:[0,1,1]
    v_pk_fma_f32 v[38:39], s[20:21], v[2:3], v[38:39] op_sel:[0,1,0] op_sel_hi:[0,1,1]
    v_pk_fma_f32 v[40:41], s[20:21], v[2:3], v[40:41] op_sel:[0,1,0] op_sel_hi:[0,1,1]
    v_pk_fma_f32 v[42:43], s[20:21], v[2:3], v[42:43] op_sel:[0,1,0] op_sel_hi:[0,1,1]
    v_pk_mul_f32 v[44:45], v[36:37], v[36:37]
    v_pk_mul_f32 v[46:47], v[38:39], v[38:39]
    v_pk_fma_f32 v[44:45], v[40:41], v[40:41], v[44:45]
    v_pk_fma_f32 v[46:47], v[42:43], v[42:43], v[46:47]
    v_pk_add_f32 v[44:45], v[44:45], v[46:47]
    v_add_f32 v44, v44, v45
    v_lshlrev_b32 v34, 16, v19
    v_and_b32 v35, s19, v19
    v_add_f32_dpp v44, v44, v44 quad_perm:[1,0,3,2] row_mask:0xf bank_mask:0xf
    v_pk_mul_f32 v[36:37], v[36:37], v[20:21]
    v_pk_mul_f32 v[38:39], v[38:39], v[22:23]
    v_add_f32_dpp v44, v44, v44 quad_perm:[2,3,0,1] row_mask:0xf bank_mask:0xf
    v_pk_mul_f32 v[40:41], v[40:41], v[24:25]
    v_pk_mul_f32 v[42:43], v[42:43], v[26:27]
    v_add_f32_dpp v44, v44, v44 row_half_mirror row_mask:0xf bank_mask:0xf
    s_nop 1
    v_add_f32_dpp v44, v44, v44 row_mirror row_mask:0xf bank_mask:0xf
    s_nop 1
    v_add_f32_dpp v44, v44, v44 row_bcast:15 row_mask:0xa bank_mask:0xf
    s_nop 1
    v_add_f32_dpp v44, v44, v44 row_bcast:31 row_mask:0xc bank_mask:0xf
    v_fma_f32 v44, v44, s18, v0
    v_rsq_f32 v44, v44
    s_nop 0
    v_readlane_b32 s22, v44, 63
    s_nop 1
    v_pk_fma_f32 v[36:37], v[36:37], s[22:23], v[28:29] op_sel_hi:[1,0,1]
    v_pk_fma_f32 v[38:39], v[38:39], s[22:23], v[30:31] op_sel_hi:[1,0,1]
    v_pk_fma_f32 v[40:41], v[40:41], s[22:23], v[32:33] op_sel_hi:[1,0,1]
    v_pk_fma_f32 v[42:43], v[42:43], s[22:23], v[34:35] op_sel_hi:[1,0,1]
    v_cvt_pk_bf16_f32 v4, v36, v37
    v_cvt_pk_bf16_f32 v5, v38, v39
    v_cvt_pk_bf16_f32 v6, v40, v41
    v_cvt_pk_bf16_f32 v7, v42, v43
    global_store_dwordx4 v1, v[4:7], s[14:15]
L_done:
    s_endpgm
.section .rodata,"a"
.p2align 6
.amdhsa_kernel standalone__deepnorm__sampling_kernel
  .amdhsa_next_free_vgpr 48
  .amdhsa_next_free_sgpr 24
  .amdhsa_accum_offset 48
  .amdhsa_group_segment_fixed_size 0
  .amdhsa_kernarg_size 64
  .amdhsa_user_sgpr_count 2
  .amdhsa_user_sgpr_kernarg_segment_ptr 1
  .amdhsa_system_sgpr_workgroup_id_x 1
  .amdhsa_float_denorm_mode_32 3
.end_amdhsa_kernel
```
